```python
import torch

def _softmax(x, axis=-1):
    return torch.softmax(x, dim=axis)
def _gelu(x):
    return torch.nn.functional.gelu(x, approximate="tanh")
def _silu(x):
    return torch.nn.functional.silu(x)
def _sigmoid(x):
    return torch.sigmoid(x)
def _layernorm(x, axis=-1, eps=1e-5):
    m = x.mean(dim=axis, keepdim=True)
    v = x.var(dim=axis, keepdim=True, unbiased=False)
    return (x - m) / torch.sqrt(v + eps)
def _scatter_add(tgt, idx, src, axis=0):
    return tgt.clone().index_add_(axis, idx, src)
def _segment_sum(src, seg, n):
    out = torch.zeros((n,) + src.shape[1:], dtype=src.dtype)
    return out.index_add_(0, seg, src)
def _pad(x, pw):
    flat = tuple(v for pair in reversed(pw) for v in pair)
    return torch.nn.functional.pad(x, flat)

kernel_name = 'standalone__gqa_softmax__sampling'

def setup_inputs():

    _w = (lambda a: (lambda t: t.to(torch.bfloat16) if t.is_floating_point() else t)(torch.as_tensor(a)))
    B, Hq, Hkv, Sq, Sk, D = 8, 32, 8, 8, 2048, 128
    return {
        "q": _w((lambda *s: torch.randn(*s, dtype=torch.bfloat16) * 0.8)(B, Hq, Sq, D)),
        "k": _w((lambda *s: torch.randn(*s, dtype=torch.bfloat16) * 0.8)(B, Hkv, Sk, D)),
        "v": _w((lambda *s: torch.randn(*s, dtype=torch.bfloat16) * 0.05)(B, Hkv, Sk, D)),
    }

def reference(q, k, v):
    B, Hq, Sq, D = q.shape
    Hkv = k.shape[1]
    rep = Hq // Hkv
    k = (lambda x, n, axis: torch.repeat_interleave(x, n, dim=axis))(k, rep, axis=1)
    v = (lambda x, n, axis: torch.repeat_interleave(x, n, dim=axis))(v, rep, axis=1)
    scale = D ** -0.5
    scores = torch.einsum("bhqd,bhkd->bhqk", q, k) * scale
    p = _softmax(scores, axis=-1)
    return torch.einsum("bhqk,bhkd->bhqd", p, v)
```

```asm
; @launch grid=(256,1,1) block=(320,1,1) lds=163840
.amdgcn_target "amdgcn-amd-amdhsa--gfx950"
.text
.p2align 13
.globl standalone__gqa_softmax__sampling_kernel
.p2align 8
.type standalone__gqa_softmax__sampling_kernel,@function
standalone__gqa_softmax__sampling_kernel:
    s_cmp_ge_u32 s2, 256
    s_cbranch_scc1 L_end
    s_load_dwordx2 s[8:9], s[0:1], 8
    s_load_dwordx2 s[4:5], s[0:1], 0
    s_load_dwordx2 s[12:13], s[0:1], 16
    s_load_dwordx2 s[16:17], s[0:1], 24
    s_load_dwordx2 s[20:21], s[0:1], 40
    v_lshrrev_b32 v36, 6, v0
    v_and_b32 v32, 63, v0
    s_and_b32 s24, s2, 7
    s_lshr_b32 s3, s2, 5
    v_readfirstlane_b32 s26, v36
    s_lshl_b32 s24, s24, 3
    s_or_b32 s24, s24, s3
    s_bfe_u32 s25, s2, 0x20003
    v_and_b32 v33, 15, v32
    v_lshrrev_b32 v34, 4, v32
    s_lshl_b32 s32, s24, 13
    s_mov_b32 s22, 0x10000000
    s_mov_b32 s23, 0x20000
    s_cmp_lg_u32 s26, 0
    s_cbranch_scc1 L_compute
    s_lshl_b32 s31, s24, 5
    s_or_b32 s31, s31, s25
    s_lshl_b32 s31, s31, 14
    s_brev_b32 s54, s3
    s_lshr_b32 s54, s54, 13
    v_xor_b32 v36, v33, v34
    v_lshlrev_b32 v36, 4, v36
    v_lshl_add_u32 v36, v34, 8, v36
    v_add_u32 v1, s31, v36
    v_xor_b32 v2, 64, v1
    v_xor_b32 v3, 0x80, v1
    v_xor_b32 v4, 0xc0, v1
    v_add_u32 v7, s32, v36
    v_xor_b32 v8, 64, v7
    v_xor_b32 v9, 0x80, v7
    v_xor_b32 v10, 0xc0, v7
    s_mov_b32 s10, 0x2000000
    s_mov_b32 s11, 0x20000
    s_mov_b32 s6, 0x80000
    s_mov_b32 s7, 0x20000
    s_movk_i32 s40, 0x1000
    s_mov_b32 s60, 0
    s_mov_b32 m0, 0
    v_mov_b32 v5, v1
    v_mov_b32 v6, v1
    v_bfrev_b32 v11, 1
    v_mov_b32 v13, 0
    s_mov_b32 s55, s54
    s_setprio 3
    s_waitcnt lgkmcnt(0)
    buffer_load_dwordx4 v1, s[8:11], s55 offen offset:0 nt lds
    buffer_load_dwordx4 v2, s[8:11], s55 offen offset:1024 nt lds
    buffer_load_dwordx4 v3, s[8:11], s55 offen offset:2048 nt lds
    buffer_load_dwordx4 v4, s[8:11], s55 offen offset:3072 nt lds
    s_mov_b32 m0, 131072
    s_nop 0
    buffer_load_dwordx4 v7, s[4:7], 0 offen offset:0 nt lds
    buffer_load_dwordx4 v8, s[4:7], 0 offen offset:1024 nt lds
    buffer_load_dwordx4 v9, s[4:7], 0 offen offset:2048 nt lds
    buffer_load_dwordx4 v10, s[4:7], 0 offen offset:3072 nt lds
    s_mov_b32 m0, 135168
    s_nop 0
    buffer_load_dwordx4 v7, s[4:7], s40 offen offset:0 nt lds
    buffer_load_dwordx4 v8, s[4:7], s40 offen offset:1024 nt lds
    buffer_load_dwordx4 v9, s[4:7], s40 offen offset:2048 nt lds
    buffer_load_dwordx4 v10, s[4:7], s40 offen offset:3072 nt lds
    s_mov_b32 m0, 0
    s_lshl_b32 s42, s24, 15
    s_add_u32 s42, s42, 1536
    s_load_dword s56, s[20:21], s42 glc
    s_branch L_tile1
L_round:
    s_waitcnt vmcnt(31)
    buffer_load_dwordx4 v1, s[8:11], s55 offen offset:0 nt lds
    s_waitcnt vmcnt(31)
    buffer_load_dwordx4 v2, s[8:11], s55 offen offset:1024 nt lds
    s_waitcnt vmcnt(31)
    buffer_load_dwordx4 v3, s[8:11], s55 offen offset:2048 nt lds
    s_waitcnt vmcnt(31)
    buffer_load_dwordx4 v4, s[8:11], s55 offen offset:3072 nt lds
L_tile1:
    s_add_u32 m0, m0, s40
    s_add_u32 s55, s55, s40
    s_waitcnt vmcnt(31)
    buffer_load_dwordx4 v1, s[8:11], s55 offen offset:0 nt lds
    s_waitcnt vmcnt(31)
    buffer_load_dwordx4 v2, s[8:11], s55 offen offset:1024 nt lds
    s_waitcnt vmcnt(31)
    buffer_load_dwordx4 v3, s[8:11], s55 offen offset:2048 nt lds
    s_waitcnt vmcnt(31)
    buffer_load_dwordx4 v4, s[8:11], s55 offen offset:3072 nt lds
    s_add_u32 m0, m0, s40
    s_add_u32 s55, s55, s40
    s_waitcnt vmcnt(31)
    buffer_load_dwordx4 v1, s[8:11], s55 offen offset:0 nt lds
    s_waitcnt vmcnt(31)
    buffer_load_dwordx4 v2, s[8:11], s55 offen offset:1024 nt lds
    s_waitcnt vmcnt(31)
    buffer_load_dwordx4 v3, s[8:11], s55 offen offset:2048 nt lds
    s_waitcnt vmcnt(31)
    buffer_load_dwordx4 v4, s[8:11], s55 offen offset:3072 nt lds
    s_add_u32 m0, m0, s40
    s_add_u32 s55, s55, s40
    s_waitcnt vmcnt(31)
    buffer_load_dwordx4 v1, s[8:11], s55 offen offset:0 nt lds
    s_waitcnt vmcnt(31)
    buffer_load_dwordx4 v2, s[8:11], s55 offen offset:1024 nt lds
    s_waitcnt vmcnt(31)
    buffer_load_dwordx4 v3, s[8:11], s55 offen offset:2048 nt lds
    s_waitcnt vmcnt(31)
    buffer_load_dwordx4 v4, s[8:11], s55 offen offset:3072 nt lds
    s_cmp_lt_u32 s60, 2
    s_cbranch_scc1 L_nobar
    s_barrier
L_nobar:
    s_add_u32 m0, m0, s40
    s_add_u32 s54, s54, 0x10000
    s_and_b32 s54, s54, 0x70000
    s_cmp_eq_u32 m0, 163840
    s_cselect_b32 m0, 0, m0
    s_mov_b32 s55, s54
    s_bitcmp1_b32 0x28a, s60
    s_cbranch_scc1 L_special
L_ret:
    s_add_u32 s60, s60, 1
    s_cmp_lt_u32 s60, 16
    s_cbranch_scc1 L_round
    s_waitcnt vmcnt(16)
    s_barrier
    s_waitcnt vmcnt(8)
    s_barrier
    s_waitcnt vmcnt(0)
    s_barrier
    s_endpgm
.p2align 8
L_special:
    s_cmp_eq_u32 s60, 1
    s_cbranch_scc0 L_sp2
    v_lshlrev_b32 v38, 1, v34
    v_xor_b32 v38, v33, v38
    v_lshlrev_b32 v38, 4, v38
    v_lshl_add_u32 v38, v34, 8, v38
    v_add_u32 v5, s31, v38
    v_xor_b32 v6, 0x80, v5
    s_getreg_b32 s39, hwreg(HW_REG_XCC_ID)
    s_sub_u32 s44, s42, 512
    s_lshl_b32 s45, s25, 2
    s_add_u32 s45, s45, s44
    v_mov_b32 v11, s45
    v_mov_b32 v12, 0xf0000000
    v_cmp_ne_u32 vcc, 0, v32
    s_and_b32 s39, s39, 0xfff
    s_lshl_b32 s39, s39, 20
    v_cndmask_b32 v11, v11, v12, vcc
    v_mov_b32 v13, 98816
    s_branch L_ret
L_sp2:
    s_cmp_eq_u32 s60, 3
    s_cbranch_scc0 L_sp3
    s_waitcnt lgkmcnt(0)
    s_add_u32 s56, s56, 1
    s_xor_b32 s39, s39, s56
    v_mov_b32 v14, s39
    buffer_store_dword v14, v11, s[20:23], 0 offen
    s_branch L_ret
L_sp3:
    s_cmp_eq_u32 s60, 9
    s_cbranch_scc1 L_sp4
    s_cmp_eq_u32 s60, 7
    s_cbranch_scc0 L_sp5
    s_load_dwordx4 s[48:51], s[20:21], s44
L_sp5:
    s_cmp_eq_u32 s60, 7
    s_cbranch_scc0 L_ret
    s_mov_b64 s[8:9], s[12:13]
    v_mov_b32 v1, v5
    v_mov_b32 v2, v6
    v_mov_b32 v3, v5
    v_mov_b32 v4, v6
    s_branch L_ret
L_sp4:
    s_waitcnt lgkmcnt(0)
    s_xor_b32 s48, s48, s39
    s_xor_b32 s49, s49, s39
    s_xor_b32 s50, s50, s39
    s_xor_b32 s51, s51, s39
    s_or_b32 s48, s48, s49
    s_or_b32 s50, s50, s51
    s_or_b32 s48, s48, s50
    v_mov_b32 v14, s56
    v_mov_b32 v15, s48
    ds_write_b64 v13, v[14:15]
    s_waitcnt lgkmcnt(0)
    s_branch L_ret
L_compute:
    s_sub_u32 s26, s26, 1
    v_subrev_u32 v0, 64, v0
    s_lshl_b32 s33, s24, 15
    s_add_u32 s42, s33, 1536
    v_mov_b32 v35, s42
    s_lshl_b32 s27, s26, 12
    s_mov_b32 s18, 0x80000
    s_mov_b32 s19, 0x20000
    s_mov_b32 s28, 0x3e0293ee
    s_mov_b32 s29, 0x3e0293ee
    s_mov_b32 s30, 0xfffffc00
    v_xor_b32 v36, v33, v34
    v_lshlrev_b32 v36, 4, v36
    v_lshl_add_u32 v36, v33, 8, v36
    v_add_u32 v1, s27, v36
    v_xor_b32 v2, 64, v1
    v_xor_b32 v3, 0x80, v1
    v_xor_b32 v4, 0xc0, v1
    v_add_u32 v120, 0x20000, v36
    v_xor_b32 v121, 64, v120
    v_xor_b32 v122, 0x80, v120
    v_xor_b32 v123, 0xc0, v120
    v_lshrrev_b32 v36, 2, v32
    v_and_b32 v38, 7, v36
    s_lshl_b32 s3, s26, 1
    v_xor_b32 v38, s3, v38
    v_lshlrev_b32 v38, 5, v38
    v_lshl_add_u32 v38, v36, 8, v38
    v_and_b32 v37, 3, v32
    v_lshl_add_u32 v5, v37, 3, v38
    v_xor_b32 v6, 32, v5
    v_add_u32 v7, 0x10000, v5
    v_add_u32 v8, 0x10000, v6
    v_add_u32 v9, 0x20000, v5
    v_add_u32 v10, 0x20000, v6
    v_mov_b32 v39, 0xf0000000
    v_mov_b32 v24, 98816
    s_lshr_b32 s38, s25, 1
    s_lshl_b32 s3, s38, 12
    s_add_u32 s31, s3, s32
    s_add_u32 s3, s25, 1
    v_add_u32 v26, s3, v36
    v_and_b32 v26, 3, v26
    v_lshlrev_b32 v26, 11, v26
    v_lshl_add_u32 v26, v37, 7, v26
    s_lshl_b32 s34, s26, 9
    s_add_u32 s44, s33, s34
    s_lshl_b32 s3, s25, 13
    s_add_u32 s45, s44, s3
    v_add_u32 v26, s45, v26
    v_cmp_le_u32 vcc, 12, v32
    s_nop 1
    v_cndmask_b32 v26, v26, v39, vcc
    v_lshlrev_b32 v12, 4, v32
    v_add_u32 v12, 0x10000, v12
    s_and_b32 s3, s26, 1
    s_lshl_b32 s3, s3, 3
    s_lshr_b32 s34, s26, 1
    s_lshl_b32 s34, s34, 11
    s_add_u32 s3, s3, s34
    v_add_u32 v11, s3, v12
    v_lshlrev_b32 v14, 3, v33
    v_add_u32 v14, 0x18000, v14
    v_add_u32 v13, s27, v14
    v_and_b32 v36, 7, v33
    v_lshl_add_u32 v36, v34, 3, v36
    v_lshlrev_b32 v36, 4, v36
    v_lshrrev_b32 v38, 3, v33
    v_lshl_add_u32 v18, v38, 3, v36
    v_add_u32 v18, s45, v18
    s_lshl_b32 s34, s25, 11
    s_add_u32 s34, s34, s44
    v_add_u32 v36, s34, v36
    v_lshrrev_b32 v38, 3, v33
    v_lshl_add_u32 v16, v38, 13, v36
    v_add_u32 v17, 0x4000, v16
    v_cmp_eq_u32 vcc, s25, v38
    s_nop 1
    v_cndmask_b32 v16, v16, v39, vcc
    v_add_u32 v38, 2, v38
    v_cmp_eq_u32 vcc, s25, v38
    s_nop 1
    v_cndmask_b32 v17, v17, v39, vcc
    s_add_u32 s35, s25, 1
    s_and_b32 s35, s35, 3
    s_lshl_b32 s35, s35, 11
    s_add_u32 s36, s25, 2
    s_and_b32 s36, s36, 3
    s_lshl_b32 s36, s36, 11
    s_add_u32 s37, s25, 3
    s_and_b32 s37, s37, 3
    s_lshl_b32 s37, s37, 11
    v_add_u32 v36, s25, v34
    v_and_b32 v36, 3, v36
    v_mul_u32_u24 v36, 0x2800, v36
    s_and_b32 s3, s25, 1
    s_lshl_b32 s3, s3, 3
    v_and_or_b32 v37, v33, 7, s3
    v_lshl_add_u32 v36, v37, 4, v36
    s_lshl_b32 s34, s38, 8
    s_add_u32 s34, s34, s33
    v_add_u32 v19, s34, v36
    s_mul_i32 s34, s25, 0x2800
    s_add_u32 s34, s34, s33
    v_lshl_add_u32 v20, v32, 4, s34
    v_cmp_le_u32 vcc, 32, v0
    s_nop 1
    v_cndmask_b32 v20, v20, v39, vcc
    s_lshl_b32 s34, s26, 6
    s_add_u32 s3, s31, s34
    v_lshl_add_u32 v21, v37, 8, s3
    v_lshl_add_u32 v21, v34, 3, v21
    v_lshrrev_b32 v38, 3, v33
    v_lshl_add_u32 v21, v38, 5, v21
    s_bitcmp1_b32 s25, 0
    s_mov_b32 s48, 0x00ff00ff
    s_cselect_b32 s50, 0xff00ff00, s48
    s_mov_b32 s51, s50
    s_cselect_b64 s[54:55], -1, 0
    s_cmp_eq_u32 s38, 1
    s_cselect_b64 s[52:53], -1, 0
    s_mov_b32 s49, 1048576
    s_mov_b32 s46, 0xffff0000
    s_waitcnt lgkmcnt(0)
    s_barrier
    ds_read_b128 a[0:3], v120 offset:0
    ds_read_b128 a[4:7], v121 offset:0
    ds_read_b128 a[8:11], v122 offset:0
    ds_read_b128 a[12:15], v123 offset:0
    ds_read_b128 a[16:19], v120 offset:4096
    ds_read_b128 a[20:23], v121 offset:4096
    ds_read_b128 a[24:27], v122 offset:4096
    ds_read_b128 a[28:31], v123 offset:4096
    ds_read_b128 v[104:107], v1 offset:0
    ds_read_b128 v[108:111], v2 offset:0
    ds_read_b128 v[112:115], v3 offset:0
    ds_read_b128 v[116:119], v4 offset:0
    s_waitcnt lgkmcnt(0)
    v_mfma_f32_16x16x32_bf16 v[40:43], v[104:107], a[0:3], 0
    v_mfma_f32_16x16x32_bf16 v[44:47], v[104:107], a[16:19], 0
    v_mfma_f32_16x16x32_bf16 v[40:43], v[108:111], a[4:7], v[40:43]
    v_mfma_f32_16x16x32_bf16 v[44:47], v[108:111], a[20:23], v[44:47]
    v_mfma_f32_16x16x32_bf16 v[40:43], v[112:115], a[8:11], v[40:43]
    v_mfma_f32_16x16x32_bf16 v[44:47], v[112:115], a[24:27], v[44:47]
    v_mfma_f32_16x16x32_bf16 v[40:43], v[116:119], a[12:15], v[40:43]
    v_mfma_f32_16x16x32_bf16 v[44:47], v[116:119], a[28:31], v[44:47]
    s_barrier
    ds_read_b128 v[104:107], v1 offset:16384
    ds_read_b128 v[108:111], v2 offset:16384
    ds_read_b128 v[112:115], v3 offset:16384
    ds_read_b128 v[116:119], v4 offset:16384
    s_waitcnt lgkmcnt(0)
    v_mfma_f32_16x16x32_bf16 v[48:51], v[104:107], a[0:3], 0
    v_mfma_f32_16x16x32_bf16 v[52:55], v[104:107], a[16:19], 0
    v_mfma_f32_16x16x32_bf16 v[48:51], v[108:111], a[4:7], v[48:51]
    v_mfma_f32_16x16x32_bf16 v[52:55], v[108:111], a[20:23], v[52:55]
    v_mfma_f32_16x16x32_bf16 v[48:51], v[112:115], a[8:11], v[48:51]
    v_mfma_f32_16x16x32_bf16 v[52:55], v[112:115], a[24:27], v[52:55]
    v_mfma_f32_16x16x32_bf16 v[48:51], v[116:119], a[12:15], v[48:51]
    v_mfma_f32_16x16x32_bf16 v[52:55], v[116:119], a[28:31], v[52:55]
    v_max3_f32 v28, v40, v41, v42
    v_max_f32 v28, v28, v43
    v_max3_f32 v29, v44, v45, v46
    v_max_f32 v29, v29, v47
    s_barrier
    ds_read_b128 v[104:107], v1 offset:32768
    ds_read_b128 v[108:111], v2 offset:32768
    ds_read_b128 v[112:115], v3 offset:32768
    ds_read_b128 v[116:119], v4 offset:32768
    s_waitcnt lgkmcnt(0)
    v_mfma_f32_16x16x32_bf16 v[56:59], v[104:107], a[0:3], 0
    v_mfma_f32_16x16x32_bf16 v[60:63], v[104:107], a[16:19], 0
    v_mfma_f32_16x16x32_bf16 v[56:59], v[108:111], a[4:7], v[56:59]
    v_mfma_f32_16x16x32_bf16 v[60:63], v[108:111], a[20:23], v[60:63]
    v_mfma_f32_16x16x32_bf16 v[56:59], v[112:115], a[8:11], v[56:59]
    v_mfma_f32_16x16x32_bf16 v[60:63], v[112:115], a[24:27], v[60:63]
    v_mfma_f32_16x16x32_bf16 v[56:59], v[116:119], a[12:15], v[56:59]
    v_mfma_f32_16x16x32_bf16 v[60:63], v[116:119], a[28:31], v[60:63]
    v_max3_f32 v28, v28, v48, v49
    v_max3_f32 v28, v28, v50, v51
    v_max3_f32 v29, v29, v52, v53
    v_max3_f32 v29, v29, v54, v55
    s_barrier
    ds_read_b128 v[104:107], v1 offset:49152
    ds_read_b128 v[108:111], v2 offset:49152
    ds_read_b128 v[112:115], v3 offset:49152
    ds_read_b128 v[116:119], v4 offset:49152
    v_add_u32 v1, 0x10000, v1
    v_add_u32 v2, 0x10000, v2
    v_add_u32 v3, 0x10000, v3
    v_add_u32 v4, 0x10000, v4
    s_waitcnt lgkmcnt(0)
    v_mfma_f32_16x16x32_bf16 v[64:67], v[104:107], a[0:3], 0
    v_mfma_f32_16x16x32_bf16 v[68:71], v[104:107], a[16:19], 0
    v_mfma_f32_16x16x32_bf16 v[64:67], v[108:111], a[4:7], v[64:67]
    v_mfma_f32_16x16x32_bf16 v[68:71], v[108:111], a[20:23], v[68:71]
    v_mfma_f32_16x16x32_bf16 v[64:67], v[112:115], a[8:11], v[64:67]
    v_mfma_f32_16x16x32_bf16 v[68:71], v[112:115], a[24:27], v[68:71]
    v_mfma_f32_16x16x32_bf16 v[64:67], v[116:119], a[12:15], v[64:67]
    v_mfma_f32_16x16x32_bf16 v[68:71], v[116:119], a[28:31], v[68:71]
    v_max3_f32 v28, v28, v56, v57
    v_max3_f32 v28, v28, v58, v59
    v_max3_f32 v29, v29, v60, v61
    v_max3_f32 v29, v29, v62, v63
    s_barrier
    ds_read_b128 v[104:107], v1 offset:0
    ds_read_b128 v[108:111], v2 offset:0
    ds_read_b128 v[112:115], v3 offset:0
    ds_read_b128 v[116:119], v4 offset:0
    s_waitcnt lgkmcnt(0)
    v_mfma_f32_16x16x32_bf16 v[72:75], v[104:107], a[0:3], 0
    v_mfma_f32_16x16x32_bf16 v[76:79], v[104:107], a[16:19], 0
    v_mfma_f32_16x16x32_bf16 v[72:75], v[108:111], a[4:7], v[72:75]
    v_mfma_f32_16x16x32_bf16 v[76:79], v[108:111], a[20:23], v[76:79]
    v_mfma_f32_16x16x32_bf16 v[72:75], v[112:115], a[8:11], v[72:75]
    v_mfma_f32_16x16x32_bf16 v[76:79], v[112:115], a[24:27], v[76:79]
    v_mfma_f32_16x16x32_bf16 v[72:75], v[116:119], a[12:15], v[72:75]
    v_mfma_f32_16x16x32_bf16 v[76:79], v[116:119], a[28:31], v[76:79]
    v_max3_f32 v28, v28, v64, v65
    v_max3_f32 v28, v28, v66, v67
    v_max3_f32 v29, v29, v68, v69
    v_max3_f32 v29, v29, v70, v71
    s_barrier
    ds_read_b128 v[104:107], v1 offset:16384
    ds_read_b128 v[108:111], v2 offset:16384
    ds_read_b128 v[112:115], v3 offset:16384
    ds_read_b128 v[116:119], v4 offset:16384
    s_waitcnt lgkmcnt(0)
    v_mfma_f32_16x16x32_bf16 v[80:83], v[104:107], a[0:3], 0
    v_mfma_f32_16x16x32_bf16 v[84:87], v[104:107], a[16:19], 0
    v_mfma_f32_16x16x32_bf16 v[80:83], v[108:111], a[4:7], v[80:83]
    v_mfma_f32_16x16x32_bf16 v[84:87], v[108:111], a[20:23], v[84:87]
    v_mfma_f32_16x16x32_bf16 v[80:83], v[112:115], a[8:11], v[80:83]
    v_mfma_f32_16x16x32_bf16 v[84:87], v[112:115], a[24:27], v[84:87]
    v_mfma_f32_16x16x32_bf16 v[80:83], v[116:119], a[12:15], v[80:83]
    v_mfma_f32_16x16x32_bf16 v[84:87], v[116:119], a[28:31], v[84:87]
    v_max3_f32 v28, v28, v72, v73
    v_max3_f32 v28, v28, v74, v75
    v_max3_f32 v29, v29, v76, v77
    v_max3_f32 v29, v29, v78, v79
    s_barrier
    ds_read_b128 v[104:107], v1 offset:32768
    ds_read_b128 v[108:111], v2 offset:32768
    ds_read_b128 v[112:115], v3 offset:32768
    ds_read_b128 v[116:119], v4 offset:32768
    s_waitcnt lgkmcnt(0)
    v_mfma_f32_16x16x32_bf16 v[88:91], v[104:107], a[0:3], 0
    v_mfma_f32_16x16x32_bf16 v[92:95], v[104:107], a[16:19], 0
    v_mfma_f32_16x16x32_bf16 v[88:91], v[108:111], a[4:7], v[88:91]
    v_mfma_f32_16x16x32_bf16 v[92:95], v[108:111], a[20:23], v[92:95]
    v_mfma_f32_16x16x32_bf16 v[88:91], v[112:115], a[8:11], v[88:91]
    v_mfma_f32_16x16x32_bf16 v[92:95], v[112:115], a[24:27], v[92:95]
    v_mfma_f32_16x16x32_bf16 v[88:91], v[116:119], a[12:15], v[88:91]
    v_mfma_f32_16x16x32_bf16 v[92:95], v[116:119], a[28:31], v[92:95]
    v_max3_f32 v28, v28, v80, v81
    v_max3_f32 v28, v28, v82, v83
    v_max3_f32 v29, v29, v84, v85
    v_max3_f32 v29, v29, v86, v87
    s_barrier
    ds_read_b128 v[104:107], v1 offset:49152
    ds_read_b128 v[108:111], v2 offset:49152
    ds_read_b128 v[112:115], v3 offset:49152
    ds_read_b128 v[116:119], v4 offset:49152
    s_waitcnt lgkmcnt(0)
    v_mfma_f32_16x16x32_bf16 v[96:99], v[104:107], a[0:3], 0
    v_mfma_f32_16x16x32_bf16 v[100:103], v[104:107], a[16:19], 0
    v_mfma_f32_16x16x32_bf16 v[96:99], v[108:111], a[4:7], v[96:99]
    v_mfma_f32_16x16x32_bf16 v[100:103], v[108:111], a[20:23], v[100:103]
    v_mfma_f32_16x16x32_bf16 v[96:99], v[112:115], a[8:11], v[96:99]
    v_mfma_f32_16x16x32_bf16 v[100:103], v[112:115], a[24:27], v[100:103]
    v_mfma_f32_16x16x32_bf16 v[96:99], v[116:119], a[12:15], v[96:99]
    v_mfma_f32_16x16x32_bf16 v[100:103], v[116:119], a[28:31], v[100:103]
    v_max3_f32 v28, v28, v88, v89
    v_max3_f32 v28, v28, v90, v91
    v_max3_f32 v29, v29, v92, v93
    v_max3_f32 v29, v29, v94, v95
    s_nop 2
    v_max3_f32 v28, v28, v96, v97
    v_max3_f32 v28, v28, v98, v99
    v_max3_f32 v29, v29, v100, v101
    v_max3_f32 v29, v29, v102, v103
    v_mov_b32 v120, v28
    v_mov_b32 v121, v29
    s_nop 0
    v_permlane16_swap_b32 v120, v28
    v_permlane16_swap_b32 v121, v29
    v_max_f32 v28, v28, v120
    v_max_f32 v29, v29, v121
    v_mov_b32 v120, v28
    v_mov_b32 v121, v29
    s_nop 0
    v_permlane32_swap_b32 v120, v28
    v_permlane32_swap_b32 v121, v29
    v_max_f32 v28, v28, v120
    v_max_f32 v29, v29, v121
    ds_write_b64 v13, v[28:29]
    s_waitcnt lgkmcnt(0)
    s_barrier
    ds_read2st64_b64 v[120:123], v14 offset0:0 offset1:8
    ds_read2st64_b64 v[124:127], v14 offset0:16 offset1:24
    ds_read_b64 v[22:23], v24
    s_waitcnt lgkmcnt(0)
    v_and_b32 v15, 0x3ff, v22
    v_bfe_u32 v25, v22, 8, 10
    v_bfe_u32 v27, v22, 16, 10
    v_bfe_u32 v30, v22, 22, 10
    v_cmp_ne_u32 s[40:41], 0, v23
    v_max3_f32 v28, v120, v122, v124
    v_max3_f32 v29, v121, v123, v125
    v_max_f32 v28, v28, v126
    v_max_f32 v29, v29, v127
    v_pk_add_f32 v[40:41], v[40:41], v[28:29] op_sel_hi:[1,0] neg_lo:[0,1] neg_hi:[0,1]
    v_pk_add_f32 v[42:43], v[42:43], v[28:29] op_sel_hi:[1,0] neg_lo:[0,1] neg_hi:[0,1]
    v_pk_mul_f32 v[40:41], v[40:41], s[28:29]
    v_pk_mul_f32 v[42:43], v[42:43], s[28:29]
    v_exp_f32 v40, v40
    v_exp_f32 v41, v41
    v_exp_f32 v42, v42
    v_exp_f32 v43, v43
    v_pk_add_f32 v[44:45], v[44:45], v[28:29] op_sel:[0,1] op_sel_hi:[1,1] neg_lo:[0,1] neg_hi:[0,1]
    v_pk_add_f32 v[46:47], v[46:47], v[28:29] op_sel:[0,1] op_sel_hi:[1,1] neg_lo:[0,1] neg_hi:[0,1]
    v_pk_mul_f32 v[44:45], v[44:45], s[28:29]
    v_pk_mul_f32 v[46:47], v[46:47], s[28:29]
    v_exp_f32 v44, v44
    v_exp_f32 v45, v45
    v_exp_f32 v46, v46
    v_exp_f32 v47, v47
    v_cvt_pk_bf16_f32 v40, v40, v41
    v_cvt_pk_bf16_f32 v41, v42, v43
    v_cvt_pk_bf16_f32 v44, v44, v45
    v_cvt_pk_bf16_f32 v45, v46, v47
    v_pk_add_f32 v[48:49], v[48:49], v[28:29] op_sel_hi:[1,0] neg_lo:[0,1] neg_hi:[0,1]
    v_pk_add_f32 v[50:51], v[50:51], v[28:29] op_sel_hi:[1,0] neg_lo:[0,1] neg_hi:[0,1]
    v_pk_mul_f32 v[48:49], v[48:49], s[28:29]
    v_pk_mul_f32 v[50:51], v[50:51], s[28:29]
    v_exp_f32 v48, v48
    v_exp_f32 v49, v49
    v_exp_f32 v50, v50
    v_exp_f32 v51, v51
    v_pk_add_f32 v[52:53], v[52:53], v[28:29] op_sel:[0,1] op_sel_hi:[1,1] neg_lo:[0,1] neg_hi:[0,1]
    v_pk_add_f32 v[54:55], v[54:55], v[28:29] op_sel:[0,1] op_sel_hi:[1,1] neg_lo:[0,1] neg_hi:[0,1]
    v_pk_mul_f32 v[52:53], v[52:53], s[28:29]
    v_pk_mul_f32 v[54:55], v[54:55], s[28:29]
    v_exp_f32 v52, v52
    v_exp_f32 v53, v53
    v_exp_f32 v54, v54
    v_exp_f32 v55, v55
    v_cvt_pk_bf16_f32 v48, v48, v49
    v_cvt_pk_bf16_f32 v49, v50, v51
    v_cvt_pk_bf16_f32 v52, v52, v53
    v_cvt_pk_bf16_f32 v53, v54, v55
    v_pk_add_f32 v[56:57], v[56:57], v[28:29] op_sel_hi:[1,0] neg_lo:[0,1] neg_hi:[0,1]
    v_pk_add_f32 v[58:59], v[58:59], v[28:29] op_sel_hi:[1,0] neg_lo:[0,1] neg_hi:[0,1]
    v_pk_mul_f32 v[56:57], v[56:57], s[28:29]
    v_pk_mul_f32 v[58:59], v[58:59], s[28:29]
    v_exp_f32 v56, v56
    v_exp_f32 v57, v57
    v_exp_f32 v58, v58
    v_exp_f32 v59, v59
    v_pk_add_f32 v[60:61], v[60:61], v[28:29] op_sel:[0,1] op_sel_hi:[1,1] neg_lo:[0,1] neg_hi:[0,1]
    v_pk_add_f32 v[62:63], v[62:63], v[28:29] op_sel:[0,1] op_sel_hi:[1,1] neg_lo:[0,1] neg_hi:[0,1]
    v_pk_mul_f32 v[60:61], v[60:61], s[28:29]
    v_pk_mul_f32 v[62:63], v[62:63], s[28:29]
    v_exp_f32 v60, v60
    v_exp_f32 v61, v61
    v_exp_f32 v62, v62
    v_exp_f32 v63, v63
    v_cvt_pk_bf16_f32 v56, v56, v57
    v_cvt_pk_bf16_f32 v57, v58, v59
    v_cvt_pk_bf16_f32 v60, v60, v61
    v_cvt_pk_bf16_f32 v61, v62, v63
    v_pk_add_f32 v[64:65], v[64:65], v[28:29] op_sel_hi:[1,0] neg_lo:[0,1] neg_hi:[0,1]
    v_pk_add_f32 v[66:67], v[66:67], v[28:29] op_sel_hi:[1,0] neg_lo:[0,1] neg_hi:[0,1]
    v_pk_mul_f32 v[64:65], v[64:65], s[28:29]
    v_pk_mul_f32 v[66:67], v[66:67], s[28:29]
    v_exp_f32 v64, v64
    v_exp_f32 v65, v65
    v_exp_f32 v66, v66
    v_exp_f32 v67, v67
    v_pk_add_f32 v[68:69], v[68:69], v[28:29] op_sel:[0,1] op_sel_hi:[1,1] neg_lo:[0,1] neg_hi:[0,1]
    v_pk_add_f32 v[70:71], v[70:71], v[28:29] op_sel:[0,1] op_sel_hi:[1,1] neg_lo:[0,1] neg_hi:[0,1]
    v_pk_mul_f32 v[68:69], v[68:69], s[28:29]
    v_pk_mul_f32 v[70:71], v[70:71], s[28:29]
    v_exp_f32 v68, v68
    v_exp_f32 v69, v69
    v_exp_f32 v70, v70
    v_exp_f32 v71, v71
    v_cvt_pk_bf16_f32 v64, v64, v65
    v_cvt_pk_bf16_f32 v65, v66, v67
    v_cvt_pk_bf16_f32 v68, v68, v69
    v_cvt_pk_bf16_f32 v69, v70, v71
    s_barrier
    ds_write_b64 v11, v[40:41] offset:32768
    ds_write_b64 v11, v[44:45] offset:33792
    ds_write_b64 v11, v[48:49] offset:36864
    ds_write_b64 v11, v[52:53] offset:37888
    ds_write_b64 v11, v[56:57] offset:40960
    ds_write_b64 v11, v[60:61] offset:41984
    ds_write_b64 v11, v[64:65] offset:45056
    ds_write_b64 v11, v[68:69] offset:46080
    v_pk_add_f32 v[72:73], v[72:73], v[28:29] op_sel_hi:[1,0] neg_lo:[0,1] neg_hi:[0,1]
    v_pk_add_f32 v[74:75], v[74:75], v[28:29] op_sel_hi:[1,0] neg_lo:[0,1] neg_hi:[0,1]
    v_pk_mul_f32 v[72:73], v[72:73], s[28:29]
    v_pk_mul_f32 v[74:75], v[74:75], s[28:29]
    v_exp_f32 v72, v72
    v_exp_f32 v73, v73
    v_exp_f32 v74, v74
    v_exp_f32 v75, v75
    v_pk_add_f32 v[76:77], v[76:77], v[28:29] op_sel:[0,1] op_sel_hi:[1,1] neg_lo:[0,1] neg_hi:[0,1]
    v_pk_add_f32 v[78:79], v[78:79], v[28:29] op_sel:[0,1] op_sel_hi:[1,1] neg_lo:[0,1] neg_hi:[0,1]
    v_pk_mul_f32 v[76:77], v[76:77], s[28:29]
    v_pk_mul_f32 v[78:79], v[78:79], s[28:29]
    v_exp_f32 v76, v76
    v_exp_f32 v77, v77
    v_exp_f32 v78, v78
    v_exp_f32 v79, v79
    v_cvt_pk_bf16_f32 v72, v72, v73
    v_cvt_pk_bf16_f32 v73, v74, v75
    v_cvt_pk_bf16_f32 v76, v76, v77
    v_cvt_pk_bf16_f32 v77, v78, v79
    ds_write_b64 v11, v[72:73] offset:49152
    ds_write_b64 v11, v[76:77] offset:50176
    v_pk_add_f32 v[80:81], v[80:81], v[28:29] op_sel_hi:[1,0] neg_lo:[0,1] neg_hi:[0,1]
    v_pk_add_f32 v[82:83], v[82:83], v[28:29] op_sel_hi:[1,0] neg_lo:[0,1] neg_hi:[0,1]
    v_pk_mul_f32 v[80:81], v[80:81], s[28:29]
    v_pk_mul_f32 v[82:83], v[82:83], s[28:29]
    v_exp_f32 v80, v80
    v_exp_f32 v81, v81
    v_exp_f32 v82, v82
    v_exp_f32 v83, v83
    v_pk_add_f32 v[84:85], v[84:85], v[28:29] op_sel:[0,1] op_sel_hi:[1,1] neg_lo:[0,1] neg_hi:[0,1]
    v_pk_add_f32 v[86:87], v[86:87], v[28:29] op_sel:[0,1] op_sel_hi:[1,1] neg_lo:[0,1] neg_hi:[0,1]
    v_pk_mul_f32 v[84:85], v[84:85], s[28:29]
    v_pk_mul_f32 v[86:87], v[86:87], s[28:29]
    v_exp_f32 v84, v84
    v_exp_f32 v85, v85
    v_exp_f32 v86, v86
    v_exp_f32 v87, v87
    v_cvt_pk_bf16_f32 v80, v80, v81
    v_cvt_pk_bf16_f32 v81, v82, v83
    v_cvt_pk_bf16_f32 v84, v84, v85
    v_cvt_pk_bf16_f32 v85, v86, v87
    ds_write_b64 v11, v[80:81] offset:53248
    ds_write_b64 v11, v[84:85] offset:54272
    v_pk_add_f32 v[88:89], v[88:89], v[28:29] op_sel_hi:[1,0] neg_lo:[0,1] neg_hi:[0,1]
    v_pk_add_f32 v[90:91], v[90:91], v[28:29] op_sel_hi:[1,0] neg_lo:[0,1] neg_hi:[0,1]
    v_pk_mul_f32 v[88:89], v[88:89], s[28:29]
    v_pk_mul_f32 v[90:91], v[90:91], s[28:29]
    v_exp_f32 v88, v88
    v_exp_f32 v89, v89
    v_exp_f32 v90, v90
    v_exp_f32 v91, v91
    v_pk_add_f32 v[92:93], v[92:93], v[28:29] op_sel:[0,1] op_sel_hi:[1,1] neg_lo:[0,1] neg_hi:[0,1]
    v_pk_add_f32 v[94:95], v[94:95], v[28:29] op_sel:[0,1] op_sel_hi:[1,1] neg_lo:[0,1] neg_hi:[0,1]
    v_pk_mul_f32 v[92:93], v[92:93], s[28:29]
    v_pk_mul_f32 v[94:95], v[94:95], s[28:29]
    v_exp_f32 v92, v92
    v_exp_f32 v93, v93
    v_exp_f32 v94, v94
    v_exp_f32 v95, v95
    v_cvt_pk_bf16_f32 v88, v88, v89
    v_cvt_pk_bf16_f32 v89, v90, v91
    v_cvt_pk_bf16_f32 v92, v92, v93
    v_cvt_pk_bf16_f32 v93, v94, v95
    ds_write_b64 v11, v[88:89] offset:57344
    ds_write_b64 v11, v[92:93] offset:58368
    v_pk_add_f32 v[96:97], v[96:97], v[28:29] op_sel_hi:[1,0] neg_lo:[0,1] neg_hi:[0,1]
    v_pk_add_f32 v[98:99], v[98:99], v[28:29] op_sel_hi:[1,0] neg_lo:[0,1] neg_hi:[0,1]
    v_pk_mul_f32 v[96:97], v[96:97], s[28:29]
    v_pk_mul_f32 v[98:99], v[98:99], s[28:29]
    v_exp_f32 v96, v96
    v_exp_f32 v97, v97
    v_exp_f32 v98, v98
    v_exp_f32 v99, v99
    v_pk_add_f32 v[100:101], v[100:101], v[28:29] op_sel:[0,1] op_sel_hi:[1,1] neg_lo:[0,1] neg_hi:[0,1]
    v_pk_add_f32 v[102:103], v[102:103], v[28:29] op_sel:[0,1] op_sel_hi:[1,1] neg_lo:[0,1] neg_hi:[0,1]
    v_pk_mul_f32 v[100:101], v[100:101], s[28:29]
    v_pk_mul_f32 v[102:103], v[102:103], s[28:29]
    v_exp_f32 v100, v100
    v_exp_f32 v101, v101
    v_exp_f32 v102, v102
    v_exp_f32 v103, v103
    v_cvt_pk_bf16_f32 v96, v96, v97
    v_cvt_pk_bf16_f32 v97, v98, v99
    v_cvt_pk_bf16_f32 v100, v100, v101
    v_cvt_pk_bf16_f32 v101, v102, v103
    ds_write_b64 v11, v[96:97] offset:61440
    ds_write_b64 v11, v[100:101] offset:62464
    v_mov_b32 v120, -1
    v_mov_b32 v121, -1
    v_mov_b32 v122, -1
    v_mov_b32 v123, -1
    s_cmp_lg_u64 s[40:41], 0
    s_cbranch_scc1 L_sslow
    buffer_store_dwordx4 v[120:123], v16, s[20:23], 0 offen
    buffer_store_dwordx4 v[120:123], v17, s[20:23], 0 offen
L_sdone:
    s_waitcnt lgkmcnt(0)
    v_mov_b32 v64, 0x3f803f80
    v_mov_b32 v65, 0x3f803f80
    v_mov_b32 v66, 0x3f803f80
    v_mov_b32 v67, 0x3f803f80
    s_barrier
    ds_read_b128 a[0:3], v12 offset:32768
    ds_read_b128 a[4:7], v12 offset:33792
    ds_read_b128 a[8:11], v12 offset:34816
    ds_read_b128 a[12:15], v12 offset:35840
    ds_read_b128 a[16:19], v12 offset:36864
    ds_read_b128 a[20:23], v12 offset:37888
    ds_read_b128 a[24:27], v12 offset:38912
    ds_read_b128 a[28:31], v12 offset:39936
    ds_read_b128 a[32:35], v12 offset:40960
    ds_read_b128 a[36:39], v12 offset:41984
    ds_read_b128 a[40:43], v12 offset:43008
    ds_read_b128 a[44:47], v12 offset:44032
    ds_read_b128 a[48:51], v12 offset:45056
    ds_read_b128 a[52:55], v12 offset:46080
    ds_read_b128 a[56:59], v12 offset:47104
    ds_read_b128 a[60:63], v12 offset:48128
    s_waitcnt lgkmcnt(12)
    v_mfma_f32_16x16x32_bf16 v[56:59], v[64:67], a[0:3], 0
    v_mfma_f32_16x16x32_bf16 v[60:63], v[64:67], a[4:7], 0
    v_mfma_f32_16x16x32_bf16 v[56:59], v[64:67], a[8:11], v[56:59]
    v_mfma_f32_16x16x32_bf16 v[60:63], v[64:67], a[12:15], v[60:63]
    ds_read_b128 a[64:67], v12 offset:49152
    ds_read_b128 a[68:71], v12 offset:50176
    ds_read_b128 a[72:75], v12 offset:51200
    ds_read_b128 a[76:79], v12 offset:52224
    s_waitcnt lgkmcnt(12)
    v_mfma_f32_16x16x32_bf16 v[56:59], v[64:67], a[16:19], v[56:59]
    v_mfma_f32_16x16x32_bf16 v[60:63], v[64:67], a[20:23], v[60:63]
    v_mfma_f32_16x16x32_bf16 v[56:59], v[64:67], a[24:27], v[56:59]
    v_mfma_f32_16x16x32_bf16 v[60:63], v[64:67], a[28:31], v[60:63]
    ds_read_b128 a[80:83], v12 offset:53248
    ds_read_b128 a[84:87], v12 offset:54272
    ds_read_b128 a[88:91], v12 offset:55296
    ds_read_b128 a[92:95], v12 offset:56320
    s_waitcnt lgkmcnt(12)
    v_mfma_f32_16x16x32_bf16 v[56:59], v[64:67], a[32:35], v[56:59]
    v_mfma_f32_16x16x32_bf16 v[60:63], v[64:67], a[36:39], v[60:63]
    v_mfma_f32_16x16x32_bf16 v[56:59], v[64:67], a[40:43], v[56:59]
    v_mfma_f32_16x16x32_bf16 v[60:63], v[64:67], a[44:47], v[60:63]
    ds_read_b128 a[96:99], v12 offset:57344
    ds_read_b128 a[100:103], v12 offset:58368
    ds_read_b128 a[104:107], v12 offset:59392
    ds_read_b128 a[108:111], v12 offset:60416
    s_waitcnt lgkmcnt(12)
    v_mfma_f32_16x16x32_bf16 v[56:59], v[64:67], a[48:51], v[56:59]
    v_mfma_f32_16x16x32_bf16 v[60:63], v[64:67], a[52:55], v[60:63]
    v_mfma_f32_16x16x32_bf16 v[56:59], v[64:67], a[56:59], v[56:59]
    v_mfma_f32_16x16x32_bf16 v[60:63], v[64:67], a[60:63], v[60:63]
    ds_read_b128 a[112:115], v12 offset:61440
    ds_read_b128 a[116:119], v12 offset:62464
    ds_read_b128 a[120:123], v12 offset:63488
    ds_read_b128 a[124:127], v12 offset:64512
    s_waitcnt lgkmcnt(12)
    v_mfma_f32_16x16x32_bf16 v[56:59], v[64:67], a[64:67], v[56:59]
    v_mfma_f32_16x16x32_bf16 v[60:63], v[64:67], a[68:71], v[60:63]
    v_mfma_f32_16x16x32_bf16 v[56:59], v[64:67], a[72:75], v[56:59]
    v_mfma_f32_16x16x32_bf16 v[60:63], v[64:67], a[76:79], v[60:63]
    s_waitcnt lgkmcnt(8)
    v_mfma_f32_16x16x32_bf16 v[56:59], v[64:67], a[80:83], v[56:59]
    v_mfma_f32_16x16x32_bf16 v[60:63], v[64:67], a[84:87], v[60:63]
    v_mfma_f32_16x16x32_bf16 v[56:59], v[64:67], a[88:91], v[56:59]
    v_mfma_f32_16x16x32_bf16 v[60:63], v[64:67], a[92:95], v[60:63]
    s_waitcnt lgkmcnt(4)
    v_mfma_f32_16x16x32_bf16 v[56:59], v[64:67], a[96:99], v[56:59]
    v_mfma_f32_16x16x32_bf16 v[60:63], v[64:67], a[100:103], v[60:63]
    v_mfma_f32_16x16x32_bf16 v[56:59], v[64:67], a[104:107], v[56:59]
    v_mfma_f32_16x16x32_bf16 v[60:63], v[64:67], a[108:111], v[60:63]
    s_waitcnt lgkmcnt(0)
    v_mfma_f32_16x16x32_bf16 v[56:59], v[64:67], a[112:115], v[56:59]
    v_mfma_f32_16x16x32_bf16 v[60:63], v[64:67], a[116:119], v[60:63]
    v_mfma_f32_16x16x32_bf16 v[56:59], v[64:67], a[120:123], v[56:59]
    v_mfma_f32_16x16x32_bf16 v[60:63], v[64:67], a[124:127], v[60:63]
    ds_read_b64_tr_b16 v[68:69], v9 offset:0
    ds_read_b64_tr_b16 v[70:71], v9 offset:4096
    ds_read_b64_tr_b16 v[72:73], v10 offset:0
    ds_read_b64_tr_b16 v[74:75], v10 offset:4096
    ds_read_b64_tr_b16 v[76:77], v9 offset:8192
    ds_read_b64_tr_b16 v[78:79], v9 offset:12288
    ds_read_b64_tr_b16 v[80:81], v10 offset:8192
    ds_read_b64_tr_b16 v[82:83], v10 offset:12288
    s_waitcnt lgkmcnt(4)
    v_mfma_f32_16x16x32_bf16 v[40:43], v[68:71], a[0:3], 0
    v_mfma_f32_16x16x32_bf16 v[48:51], v[68:71], a[4:7], 0
    v_mfma_f32_16x16x32_bf16 v[44:47], v[72:75], a[0:3], 0
    v_mfma_f32_16x16x32_bf16 v[52:55], v[72:75], a[4:7], 0
    s_waitcnt lgkmcnt(0)
    v_mfma_f32_16x16x32_bf16 v[40:43], v[76:79], a[8:11], v[40:43]
    v_mfma_f32_16x16x32_bf16 v[48:51], v[76:79], a[12:15], v[48:51]
    v_mfma_f32_16x16x32_bf16 v[44:47], v[80:83], a[8:11], v[44:47]
    v_mfma_f32_16x16x32_bf16 v[52:55], v[80:83], a[12:15], v[52:55]
    v_cmp_le_u32 vcc, 16, v32
    s_nop 1
    v_cndmask_b32 v37, v28, v29, vcc
    v_cndmask_b32 v38, v56, v60, vcc
    v_and_or_b32 v84, v37, s30, v15
    v_lshl_or_b32 v85, v37, 10, v25
    v_and_or_b32 v86, v38, s30, v27
    v_lshl_or_b32 v87, v38, 10, v30
    s_waitcnt vmcnt(0)
    s_barrier
    s_cmp_lg_u64 s[40:41], 0
    s_cbranch_scc1 L_mlslow
    buffer_store_dwordx4 v[84:87], v20, s[20:23], 0 offen
L_mlst:
    ds_read_b64_tr_b16 v[68:69], v9 offset:16384
    ds_read_b64_tr_b16 v[70:71], v9 offset:20480
    ds_read_b64_tr_b16 v[72:73], v10 offset:16384
    ds_read_b64_tr_b16 v[74:75], v10 offset:20480
    ds_read_b64_tr_b16 v[76:77], v9 offset:24576
    ds_read_b64_tr_b16 v[78:79], v9 offset:28672
    ds_read_b64_tr_b16 v[80:81], v10 offset:24576
    ds_read_b64_tr_b16 v[82:83], v10 offset:28672
    s_waitcnt lgkmcnt(4)
    v_mfma_f32_16x16x32_bf16 v[40:43], v[68:71], a[16:19], v[40:43]
    v_mfma_f32_16x16x32_bf16 v[48:51], v[68:71], a[20:23], v[48:51]
    v_mfma_f32_16x16x32_bf16 v[44:47], v[72:75], a[16:19], v[44:47]
    v_mfma_f32_16x16x32_bf16 v[52:55], v[72:75], a[20:23], v[52:55]
    s_waitcnt lgkmcnt(0)
    v_mfma_f32_16x16x32_bf16 v[40:43], v[76:79], a[24:27], v[40:43]
    v_mfma_f32_16x16x32_bf16 v[48:51], v[76:79], a[28:31], v[48:51]
    v_mfma_f32_16x16x32_bf16 v[44:47], v[80:83], a[24:27], v[44:47]
    v_mfma_f32_16x16x32_bf16 v[52:55], v[80:83], a[28:31], v[52:55]
    ds_read_b64_tr_b16 v[68:69], v5 offset:0
    ds_read_b64_tr_b16 v[70:71], v5 offset:4096
    ds_read_b64_tr_b16 v[72:73], v6 offset:0
    ds_read_b64_tr_b16 v[74:75], v6 offset:4096
    ds_read_b64_tr_b16 v[76:77], v5 offset:8192
    ds_read_b64_tr_b16 v[78:79], v5 offset:12288
    ds_read_b64_tr_b16 v[80:81], v6 offset:8192
    ds_read_b64_tr_b16 v[82:83], v6 offset:12288
    s_waitcnt lgkmcnt(4)
    v_mfma_f32_16x16x32_bf16 v[40:43], v[68:71], a[32:35], v[40:43]
    v_mfma_f32_16x16x32_bf16 v[48:51], v[68:71], a[36:39], v[48:51]
    v_mfma_f32_16x16x32_bf16 v[44:47], v[72:75], a[32:35], v[44:47]
    v_mfma_f32_16x16x32_bf16 v[52:55], v[72:75], a[36:39], v[52:55]
    s_waitcnt lgkmcnt(0)
    v_mfma_f32_16x16x32_bf16 v[40:43], v[76:79], a[40:43], v[40:43]
    v_mfma_f32_16x16x32_bf16 v[48:51], v[76:79], a[44:47], v[48:51]
    v_mfma_f32_16x16x32_bf16 v[44:47], v[80:83], a[40:43], v[44:47]
    v_mfma_f32_16x16x32_bf16 v[52:55], v[80:83], a[44:47], v[52:55]
    ds_read_b64_tr_b16 v[68:69], v5 offset:16384
    ds_read_b64_tr_b16 v[70:71], v5 offset:20480
    ds_read_b64_tr_b16 v[72:73], v6 offset:16384
    ds_read_b64_tr_b16 v[74:75], v6 offset:20480
    ds_read_b64_tr_b16 v[76:77], v5 offset:24576
    ds_read_b64_tr_b16 v[78:79], v5 offset:28672
    ds_read_b64_tr_b16 v[80:81], v6 offset:24576
    ds_read_b64_tr_b16 v[82:83], v6 offset:28672
    s_waitcnt lgkmcnt(4)
    v_mfma_f32_16x16x32_bf16 v[40:43], v[68:71], a[48:51], v[40:43]
    v_mfma_f32_16x16x32_bf16 v[48:51], v[68:71], a[52:55], v[48:51]
    v_mfma_f32_16x16x32_bf16 v[44:47], v[72:75], a[48:51], v[44:47]
    v_mfma_f32_16x16x32_bf16 v[52:55], v[72:75], a[52:55], v[52:55]
    s_waitcnt lgkmcnt(0)
    v_mfma_f32_16x16x32_bf16 v[40:43], v[76:79], a[56:59], v[40:43]
    v_mfma_f32_16x16x32_bf16 v[48:51], v[76:79], a[60:63], v[48:51]
    v_mfma_f32_16x16x32_bf16 v[44:47], v[80:83], a[56:59], v[44:47]
    v_mfma_f32_16x16x32_bf16 v[52:55], v[80:83], a[60:63], v[52:55]
    s_barrier
    ds_read_b64_tr_b16 v[68:69], v5 offset:32768
    ds_read_b64_tr_b16 v[70:71], v5 offset:36864
    ds_read_b64_tr_b16 v[72:73], v6 offset:32768
    ds_read_b64_tr_b16 v[74:75], v6 offset:36864
    ds_read_b64_tr_b16 v[76:77], v5 offset:40960
    ds_read_b64_tr_b16 v[78:79], v5 offset:45056
    ds_read_b64_tr_b16 v[80:81], v6 offset:40960
    ds_read_b64_tr_b16 v[82:83], v6 offset:45056
    s_waitcnt lgkmcnt(4)
    v_mfma_f32_16x16x32_bf16 v[40:43], v[68:71], a[64:67], v[40:43]
    v_mfma_f32_16x16x32_bf16 v[48:51], v[68:71], a[68:71], v[48:51]
    v_mfma_f32_16x16x32_bf16 v[44:47], v[72:75], a[64:67], v[44:47]
    v_mfma_f32_16x16x32_bf16 v[52:55], v[72:75], a[68:71], v[52:55]
    s_waitcnt lgkmcnt(0)
    v_mfma_f32_16x16x32_bf16 v[40:43], v[76:79], a[72:75], v[40:43]
    v_mfma_f32_16x16x32_bf16 v[48:51], v[76:79], a[76:79], v[48:51]
    v_mfma_f32_16x16x32_bf16 v[44:47], v[80:83], a[72:75], v[44:47]
    v_mfma_f32_16x16x32_bf16 v[52:55], v[80:83], a[76:79], v[52:55]
    buffer_load_dwordx4 v[100:103], v19, s[20:23], 0 offen sc1 nt
    s_barrier
    ds_read_b64_tr_b16 v[68:69], v5 offset:49152
    ds_read_b64_tr_b16 v[70:71], v5 offset:53248
    ds_read_b64_tr_b16 v[72:73], v6 offset:49152
    ds_read_b64_tr_b16 v[74:75], v6 offset:53248
    ds_read_b64_tr_b16 v[76:77], v5 offset:57344
    ds_read_b64_tr_b16 v[78:79], v5 offset:61440
    ds_read_b64_tr_b16 v[80:81], v6 offset:57344
    ds_read_b64_tr_b16 v[82:83], v6 offset:61440
    s_waitcnt lgkmcnt(4)
    v_mfma_f32_16x16x32_bf16 v[40:43], v[68:71], a[80:83], v[40:43]
    v_mfma_f32_16x16x32_bf16 v[48:51], v[68:71], a[84:87], v[48:51]
    v_mfma_f32_16x16x32_bf16 v[44:47], v[72:75], a[80:83], v[44:47]
    v_mfma_f32_16x16x32_bf16 v[52:55], v[72:75], a[84:87], v[52:55]
    s_waitcnt lgkmcnt(0)
    v_mfma_f32_16x16x32_bf16 v[40:43], v[76:79], a[88:91], v[40:43]
    v_mfma_f32_16x16x32_bf16 v[48:51], v[76:79], a[92:95], v[48:51]
    v_mfma_f32_16x16x32_bf16 v[44:47], v[80:83], a[88:91], v[44:47]
    v_mfma_f32_16x16x32_bf16 v[52:55], v[80:83], a[92:95], v[52:55]
    buffer_load_dword v36, v26, s[20:23], 0 offen sc1 nt
    s_barrier
    ds_read_b64_tr_b16 v[68:69], v7 offset:0
    ds_read_b64_tr_b16 v[70:71], v7 offset:4096
    ds_read_b64_tr_b16 v[72:73], v8 offset:0
    ds_read_b64_tr_b16 v[74:75], v8 offset:4096
    ds_read_b64_tr_b16 v[76:77], v7 offset:8192
    ds_read_b64_tr_b16 v[78:79], v7 offset:12288
    ds_read_b64_tr_b16 v[80:81], v8 offset:8192
    ds_read_b64_tr_b16 v[82:83], v8 offset:12288
    s_waitcnt lgkmcnt(4)
    v_mfma_f32_16x16x32_bf16 v[40:43], v[68:71], a[96:99], v[40:43]
    v_mfma_f32_16x16x32_bf16 v[48:51], v[68:71], a[100:103], v[48:51]
    v_mfma_f32_16x16x32_bf16 v[44:47], v[72:75], a[96:99], v[44:47]
    v_mfma_f32_16x16x32_bf16 v[52:55], v[72:75], a[100:103], v[52:55]
    s_waitcnt lgkmcnt(0)
    v_mfma_f32_16x16x32_bf16 v[40:43], v[76:79], a[104:107], v[40:43]
    v_mfma_f32_16x16x32_bf16 v[48:51], v[76:79], a[108:111], v[48:51]
    v_mfma_f32_16x16x32_bf16 v[44:47], v[80:83], a[104:107], v[44:47]
    v_mfma_f32_16x16x32_bf16 v[52:55], v[80:83], a[108:111], v[52:55]
    s_waitcnt vmcnt(1)
    v_xor_b32 v92, v100, v15
    v_bitop3_b32 v92, v92, v101, v25 bitop3:0xf6
    v_bitop3_b32 v92, v92, v102, v27 bitop3:0xf6
    v_bitop3_b32 v92, v92, v103, v30 bitop3:0xf6
    v_and_b32 v92, 0x3ff, v92
    v_cmp_ne_u32 s[58:59], 0, v92
    v_bfe_u32 v86, v101, 10, 10
    v_bfe_u32 v87, v103, 10, 10
    v_and_or_b32 v84, v100, s30, v86
    v_and_or_b32 v85, v102, s30, v87
    v_mov_b32 v86, v84
    v_mov_b32 v87, v84
    s_nop 1
    v_permlane16_swap_b32 v86, v87
    v_max_f32 v86, v86, v87
    v_mov_b32 v87, v86
    s_nop 1
    v_permlane32_swap_b32 v86, v87
    v_max_f32 v86, v86, v87
    v_sub_f32 v84, v84, v86
    v_mul_f32 v84, s29, v84
    v_exp_f32 v84, v84
    s_nop 0
    v_mul_f32 v85, v85, v84
    v_mov_b32 v87, v85
    s_nop 1
    v_permlane16_swap_b32 v85, v87
    v_add_f32 v85, v85, v87
    v_mov_b32 v87, v85
    s_nop 1
    v_permlane32_swap_b32 v85, v87
    v_add_f32 v85, v85, v87
    v_rcp_f32 v85, v85
    s_nop 0
    v_mul_f32 v96, v84, v85
    v_mov_b32 v97, v96
    s_nop 1
    v_permlane16_swap_b32 v96, v97
    v_mov_b32 v98, v96
    v_mov_b32 v99, v97
    s_nop 0
    v_permlane32_swap_b32 v96, v98
    v_permlane32_swap_b32 v97, v99
    s_barrier
    ds_read_b64_tr_b16 v[68:69], v7 offset:16384
    ds_read_b64_tr_b16 v[70:71], v7 offset:20480
    ds_read_b64_tr_b16 v[72:73], v8 offset:16384
    ds_read_b64_tr_b16 v[74:75], v8 offset:20480
    s_waitcnt lgkmcnt(0)
    v_mfma_f32_16x16x32_bf16 v[40:43], v[68:71], a[112:115], v[40:43]
    v_mfma_f32_16x16x32_bf16 v[48:51], v[68:71], a[116:119], v[48:51]
    v_mfma_f32_16x16x32_bf16 v[44:47], v[72:75], a[112:115], v[44:47]
    v_mfma_f32_16x16x32_bf16 v[52:55], v[72:75], a[116:119], v[52:55]
    s_barrier
    ds_read_b64_tr_b16 v[76:77], v7 offset:24576
    ds_read_b64_tr_b16 v[78:79], v7 offset:28672
    ds_read_b64_tr_b16 v[80:81], v8 offset:24576
    ds_read_b64_tr_b16 v[82:83], v8 offset:28672
    buffer_load_dwordx2 v[104:105], v18, s[20:23], s35 offen sc1 nt
    buffer_load_dwordx2 v[106:107], v18, s[20:23], s36 offen sc1 nt
    buffer_load_dwordx2 v[108:109], v18, s[20:23], s37 offen sc1 nt
    s_waitcnt lgkmcnt(0)
    v_mfma_f32_16x16x32_bf16 v[40:43], v[76:79], a[120:123], v[40:43]
    v_mfma_f32_16x16x32_bf16 v[44:47], v[80:83], a[120:123], v[44:47]
    v_mfma_f32_16x16x32_bf16 v[48:51], v[76:79], a[124:127], v[48:51]
    v_mfma_f32_16x16x32_bf16 v[52:55], v[80:83], a[124:127], v[52:55]
    s_cmp_lg_u64 s[40:41], 0
    s_cbranch_scc1 L_slow
    s_nop 2
    v_cvt_pk_bf16_f32 v68, v40, v41
    v_cvt_pk_bf16_f32 v69, v42, v43
    v_cvt_pk_bf16_f32 v70, v44, v45
    v_cvt_pk_bf16_f32 v71, v46, v47
    buffer_store_dwordx4 v[68:71], v16, s[20:23], 0 offen
    v_cvt_pk_bf16_f32 v72, v48, v49
    v_cvt_pk_bf16_f32 v73, v50, v51
    v_cvt_pk_bf16_f32 v74, v52, v53
    v_cvt_pk_bf16_f32 v75, v54, v55
    buffer_store_dwordx4 v[72:75], v17, s[20:23], 0 offen
L_stored:
    s_cmp_lg_u64 s[58:59], 0
    s_cbranch_scc1 L_mlretry
    s_waitcnt vmcnt(2)
    v_max3_u32 v116, v104, v105, v106
    v_max3_u32 v117, v107, v108, v109
    v_max_u32 v116, v116, v117
    v_cmp_eq_u32 vcc, -1, v116
    s_cbranch_vccz L_mlok
    buffer_load_dwordx2 v[104:105], v18, s[20:23], s35 offen sc1 nt
    buffer_load_dwordx2 v[106:107], v18, s[20:23], s36 offen sc1 nt
    buffer_load_dwordx2 v[108:109], v18, s[20:23], s37 offen sc1 nt
L_mlok:
    v_cndmask_b32 v84, v40, v48, s[52:53]
    v_cndmask_b32 v85, v41, v49, s[52:53]
    v_cndmask_b32 v86, v42, v50, s[52:53]
    v_cndmask_b32 v87, v43, v51, s[52:53]
    v_cndmask_b32 v88, v44, v52, s[52:53]
    v_cndmask_b32 v89, v45, v53, s[52:53]
    v_cndmask_b32 v90, v46, v54, s[52:53]
    v_cndmask_b32 v91, v47, v55, s[52:53]
    v_cndmask_b32 v56, v84, v88, s[54:55]
    v_cndmask_b32 v60, v88, v84, s[54:55]
    v_cndmask_b32 v57, v85, v89, s[54:55]
    v_cndmask_b32 v61, v89, v85, s[54:55]
    v_cndmask_b32 v58, v86, v90, s[54:55]
    v_cndmask_b32 v62, v90, v86, s[54:55]
    v_cndmask_b32 v59, v87, v91, s[54:55]
    v_cndmask_b32 v63, v91, v87, s[54:55]
    v_mov_b32_dpp v84, v60 row_ror:8 row_mask:0xf bank_mask:0xf
    v_mov_b32_dpp v85, v61 row_ror:8 row_mask:0xf bank_mask:0xf
    v_mov_b32_dpp v86, v62 row_ror:8 row_mask:0xf bank_mask:0xf
    v_mov_b32_dpp v87, v63 row_ror:8 row_mask:0xf bank_mask:0xf
    v_cndmask_b32 v56, v84, v56, s[50:51]
    v_cndmask_b32 v57, v85, v57, s[50:51]
    v_cndmask_b32 v58, v86, v58, s[50:51]
    v_cndmask_b32 v59, v87, v59, s[50:51]
    v_mul_f32 v56, v56, v96
    v_mul_f32 v57, v57, v96
    v_mul_f32 v58, v58, v96
    v_mul_f32 v59, v59, v96
    s_cbranch_vccz L_got
    s_waitcnt vmcnt(0)
L_chk:
    v_max3_u32 v116, v104, v105, v106
    v_max3_u32 v117, v107, v108, v109
    v_max_u32 v116, v116, v117
    v_cmp_eq_u32 vcc, -1, v116
    s_cbranch_vccnz L_retry
L_got:
    v_lshlrev_b32 v116, 16, v104
    v_and_b32 v117, s46, v104
    v_lshlrev_b32 v118, 16, v105
    v_and_b32 v119, s46, v105
    v_pk_fma_f32 v[56:57], v[116:117], v[96:97], v[56:57] op_sel:[0,1,0] op_sel_hi:[1,1,1]
    v_pk_fma_f32 v[58:59], v[118:119], v[96:97], v[58:59] op_sel:[0,1,0] op_sel_hi:[1,1,1]
    v_lshlrev_b32 v120, 16, v106
    v_and_b32 v121, s46, v106
    v_lshlrev_b32 v122, 16, v107
    v_and_b32 v123, s46, v107
    v_pk_fma_f32 v[56:57], v[120:121], v[98:99], v[56:57] op_sel_hi:[1,0,1]
    v_pk_fma_f32 v[58:59], v[122:123], v[98:99], v[58:59] op_sel_hi:[1,0,1]
    v_lshlrev_b32 v116, 16, v108
    v_and_b32 v117, s46, v108
    v_lshlrev_b32 v118, 16, v109
    v_and_b32 v119, s46, v109
    v_pk_fma_f32 v[56:57], v[116:117], v[98:99], v[56:57] op_sel:[0,1,0] op_sel_hi:[1,1,1]
    v_pk_fma_f32 v[58:59], v[118:119], v[98:99], v[58:59] op_sel:[0,1,0] op_sel_hi:[1,1,1]
    v_cvt_pk_bf16_f32 v56, v56, v57
    v_cvt_pk_bf16_f32 v57, v58, v59
    buffer_store_dwordx2 v[56:57], v21, s[16:19], 0 offen
L_fin:
    s_or_b32 s3, s25, s26
    s_cmp_lg_u32 s3, 0
    s_cbranch_scc1 L_noep
    s_mov_b64 exec, 1
    buffer_store_dword v22, v35, s[20:23], 0 offen
L_noep:
L_end:
    s_endpgm
L_retry:
    s_sub_u32 s49, s49, 1
    s_cmp_eq_u32 s49, 0
    s_cbranch_scc1 L_got
    buffer_load_dwordx2 v[104:105], v18, s[20:23], s35 offen sc1 nt
    buffer_load_dwordx2 v[106:107], v18, s[20:23], s36 offen sc1 nt
    buffer_load_dwordx2 v[108:109], v18, s[20:23], s37 offen sc1 nt
    s_waitcnt vmcnt(0)
    s_branch L_chk
L_mlretry:
    s_sub_u32 s49, s49, 1
    s_cmp_eq_u32 s49, 0
    s_cbranch_scc1 L_end
    buffer_load_dwordx4 v[100:103], v19, s[20:23], 0 offen sc1 nt
    s_waitcnt vmcnt(0)
    v_xor_b32 v92, v100, v15
    v_bitop3_b32 v92, v92, v101, v25 bitop3:0xf6
    v_bitop3_b32 v92, v92, v102, v27 bitop3:0xf6
    v_bitop3_b32 v92, v92, v103, v30 bitop3:0xf6
    v_and_b32 v92, 0x3ff, v92
    v_cmp_ne_u32 vcc, 0, v92
    s_cbranch_vccnz L_mlretry
    buffer_load_dwordx2 v[104:105], v18, s[20:23], s35 offen sc1 nt
    buffer_load_dwordx2 v[106:107], v18, s[20:23], s36 offen sc1 nt
    buffer_load_dwordx2 v[108:109], v18, s[20:23], s37 offen sc1 nt
    v_bfe_u32 v86, v101, 10, 10
    v_bfe_u32 v87, v103, 10, 10
    v_and_or_b32 v84, v100, s30, v86
    v_and_or_b32 v85, v102, s30, v87
    v_mov_b32 v86, v84
    v_mov_b32 v87, v84
    s_nop 1
    v_permlane16_swap_b32 v86, v87
    v_max_f32 v86, v86, v87
    v_mov_b32 v87, v86
    s_nop 1
    v_permlane32_swap_b32 v86, v87
    v_max_f32 v86, v86, v87
    v_sub_f32 v84, v84, v86
    v_mul_f32 v84, s29, v84
    v_exp_f32 v84, v84
    s_nop 0
    v_mul_f32 v85, v85, v84
    v_mov_b32 v87, v85
    s_nop 1
    v_permlane16_swap_b32 v85, v87
    v_add_f32 v85, v85, v87
    v_mov_b32 v87, v85
    s_nop 1
    v_permlane32_swap_b32 v85, v87
    v_add_f32 v85, v85, v87
    v_rcp_f32 v85, v85
    s_nop 0
    v_mul_f32 v96, v84, v85
    v_mov_b32 v97, v96
    s_nop 1
    v_permlane16_swap_b32 v96, v97
    v_mov_b32 v98, v96
    v_mov_b32 v99, v97
    s_nop 0
    v_permlane32_swap_b32 v96, v98
    v_permlane32_swap_b32 v97, v99
    s_mov_b64 vcc, -1
    s_waitcnt vmcnt(0)
    s_branch L_mlok
L_slow:
    s_nop 7
    v_cvt_pk_bf16_f32 v68, v40, v41
    v_cvt_pk_bf16_f32 v69, v42, v43
    v_cvt_pk_bf16_f32 v70, v44, v45
    v_cvt_pk_bf16_f32 v71, v46, v47
    buffer_store_dwordx4 v[68:71], v16, s[20:23], 0 offen sc1
    v_cvt_pk_bf16_f32 v72, v48, v49
    v_cvt_pk_bf16_f32 v73, v50, v51
    v_cvt_pk_bf16_f32 v74, v52, v53
    v_cvt_pk_bf16_f32 v75, v54, v55
    buffer_store_dwordx4 v[72:75], v17, s[20:23], 0 offen sc1
    s_branch L_stored
L_mlslow:
    buffer_store_dwordx4 v[84:87], v20, s[20:23], 0 offen sc1
    s_branch L_mlst
L_sslow:
    buffer_store_dwordx4 v[120:123], v16, s[20:23], 0 offen sc1
    buffer_store_dwordx4 v[120:123], v17, s[20:23], 0 offen sc1
    s_branch L_sdone
L_codeend:
.section .rodata,"a"
.p2align 6
.amdhsa_kernel standalone__gqa_softmax__sampling_kernel
  .amdhsa_next_free_vgpr 256
  .amdhsa_next_free_sgpr 96
  .amdhsa_accum_offset 128
  .amdhsa_group_segment_fixed_size 0
  .amdhsa_kernarg_size 48
  .amdhsa_user_sgpr_count 2
  .amdhsa_user_sgpr_kernarg_segment_ptr 1
  .amdhsa_system_sgpr_workgroup_id_x 1
  .amdhsa_float_denorm_mode_32 3
.end_amdhsa_kernel
```
